```python
import torch

def _softmax(x, axis=-1):
    return torch.softmax(x, dim=axis)
def _gelu(x):
    return torch.nn.functional.gelu(x, approximate="tanh")
def _silu(x):
    return torch.nn.functional.silu(x)
def _sigmoid(x):
    return torch.sigmoid(x)
def _layernorm(x, axis=-1, eps=1e-5):
    m = x.mean(dim=axis, keepdim=True)
    v = x.var(dim=axis, keepdim=True, unbiased=False)
    return (x - m) / torch.sqrt(v + eps)
def _scatter_add(tgt, idx, src, axis=0):
    return tgt.clone().index_add_(axis, idx, src)
def _segment_sum(src, seg, n):
    out = torch.zeros((n,) + src.shape[1:], dtype=src.dtype)
    return out.index_add_(0, seg, src)
def _pad(x, pw):
    flat = tuple(v for pair in reversed(pw) for v in pair)
    return torch.nn.functional.pad(x, flat)

kernel_name = 'standalone__gqa_block_cached__near_ridge'

def setup_inputs():

    _w = (lambda a: (lambda t: t.to(torch.bfloat16) if t.is_floating_point() else t)(torch.as_tensor(a)))
    B, Sq, D = 8, 128, 512
    Hq, Hkv, Sk, Dh = 32, 32, 2048, 128
    assert Hq % Hkv == 0, (Hq, Hkv)
    return {
        "x": _w((lambda *s: torch.randn(*s, dtype=torch.bfloat16) * 0.8)(B, Sq, D)),
        "k_cache": _w((lambda *s: torch.randn(*s, dtype=torch.bfloat16) * 0.8)(B, Hkv, Sk, Dh)),
        "v_cache": _w((lambda *s: torch.randn(*s, dtype=torch.bfloat16) * 0.05)(B, Hkv, Sk, Dh)),
        "wq": _w((lambda *s: torch.randn(*s, dtype=torch.bfloat16) * 0.8)(D, Hq * Dh) * (D ** -0.5)),
        "wo": _w((lambda *s: torch.randn(*s, dtype=torch.bfloat16) * 0.05)(Hq * Dh, D) * ((Hq * Dh) ** -0.5)),
    }

def reference(x, k_cache, v_cache, wq, wo):
    B, Sq, D = x.shape
    Hq, Dh = 32, 128
    Hkv = k_cache.shape[1]
    rep = Hq // Hkv
    q = (lambda x, *d: x.permute(*d))((x @ wq).reshape(B, Sq, Hq, Dh), 0, 2, 1, 3)
    k = (lambda x, n, axis: torch.repeat_interleave(x, n, dim=axis))(k_cache, rep, axis=1)
    v = (lambda x, n, axis: torch.repeat_interleave(x, n, dim=axis))(v_cache, rep, axis=1)
    scores = torch.einsum("bhqd,bhkd->bhqk", q, k) * (Dh ** -0.5)
    p = _softmax(scores, axis=-1)
    o = torch.einsum("bhqk,bhkd->bhqd", p, v)
    return (lambda x, *d: x.permute(*d))(o, 0, 2, 1, 3).reshape(B, Sq, Hq * Dh) @ wo
```

```asm
; @launch kernel=standalone__gqa_block_cached__near_ridge_kernel grid=(256,1,1) block=(512,1,1) lds=163840
; @launch kernel=oproj_kernel grid=(256,1,1) block=(256,1,1) lds=147456
.amdgcn_target "amdgcn-amd-amdhsa--gfx950"
.text

.globl standalone__gqa_block_cached__near_ridge_kernel
.p2align 8
.type standalone__gqa_block_cached__near_ridge_kernel,@function
standalone__gqa_block_cached__near_ridge_kernel:
  s_cmp_ge_u32 s2, 256
  s_cbranch_scc1 L1_done
  s_load_dwordx4 s[4:7], s[0:1], 0
  s_load_dwordx4 s[8:11], s[0:1], 16
  s_load_dwordx2 s[12:13], s[0:1], 56
  v_and_b32 v1, 63, v0
  v_lshrrev_b32 v2, 6, v0
  s_nop 0
  v_readfirstlane_b32 s36, v2
  s_waitcnt lgkmcnt(0)
  s_lshl_b32 s3, s2, 19
  s_add_u32 s16, s6, s3
  s_addc_u32 s17, s7, 0
  s_mov_b32 s18, 524288
  s_mov_b32 s19, 0x20000
  s_add_u32 s20, s8, s3
  s_addc_u32 s21, s9, 0
  s_mov_b32 s22, 524288
  s_mov_b32 s23, 0x20000
  s_lshr_b32 s14, s2, 5
  s_and_b32 s15, s2, 31
  s_lshl_b32 s3, s14, 17
  s_add_u32 s24, s4, s3
  s_addc_u32 s25, s5, 0
  s_mov_b32 s26, 131072
  s_mov_b32 s27, 0x20000
  s_lshl_b32 s3, s15, 8
  s_add_u32 s28, s10, s3
  s_addc_u32 s29, s11, 0
  s_sub_u32 s30, 0x400000, s3
  s_mov_b32 s31, 0x20000
  s_lshl_b32 s14, s14, 20
  s_add_u32 s14, s14, s3
  s_add_u32 s32, s12, s14
  s_addc_u32 s33, s13, 0
  s_sub_u32 s34, 0x100000, s3
  s_mov_b32 s35, 0x20000
  s_mov_b32 s37, 0x3e0293ee
  s_lshr_b32 s43, s36, 2
  s_and_b32 s44, s36, 3
  s_lshl_b32 s41, s36, 11
  s_mov_b32 s40, s41
  s_mov_b32 s45, 0
  s_lshl_b32 s39, s36, 12
  s_lshl_b32 s42, s36, 17
  s_lshl_b32 s47, s44, 18
  s_and_b32 s3, s36, 1
  s_lshl_b32 s3, s3, 7
  v_and_b32 v2, 15, v1
  v_lshrrev_b32 v3, 4, v1
  v_xor_b32 v4, v2, v3
  v_lshlrev_b32 v4, 4, v4
  v_lshl_add_u32 v4, v3, 8, v4
  v_xor_b32 v10, s3, v4
  v_xor_b32 v11, 64, v10
  v_lshlrev_b32 v4, 2, v3
  v_xor_b32 v4, v4, v2
  v_lshlrev_b32 v4, 4, v4
  v_lshl_add_u32 v12, v3, 8, v4
  v_lshl_add_u32 v13, v3, 13, v4
  v_and_b32 v4, 31, v1
  v_lshrrev_b32 v5, 5, v1
  v_lshlrev_b32 v4, 10, v4
  v_lshl_add_u32 v4, v5, 4, v4
  s_lshl_b32 s3, s44, 15
  v_and_b32 v2, 15, v1
  v_lshrrev_b32 v3, 4, v1
  v_xor_b32 v4, v2, v3
  v_lshlrev_b32 v4, 4, v4
  v_lshl_add_u32 v4, v3, 10, v4
  v_xor_b32 v24, 0, v4
  v_xor_b32 v25, 64, v4
  v_xor_b32 v26, 128, v4
  v_xor_b32 v27, 192, v4
  s_lshl_b32 s48, s36, 14
  s_add_u32 m0, s39, 32768
  s_add_u32 s38, s42, 0
  buffer_load_dwordx4 v13, s[28:31], s38 offen lds
  s_add_u32 m0, s39, 33792
  s_add_u32 s38, s42, 32768
  buffer_load_dwordx4 v13, s[28:31], s38 offen lds
  s_add_u32 m0, s39, 34816
  s_add_u32 s38, s42, 65536
  buffer_load_dwordx4 v13, s[28:31], s38 offen lds
  s_add_u32 m0, s39, 35840
  s_add_u32 s38, s42, 98304
  buffer_load_dwordx4 v13, s[28:31], s38 offen lds
  s_add_u32 m0, s39, 65536
  s_add_u32 s38, s48, 0
  buffer_load_dwordx4 v24, s[24:27], s38 offen lds
  s_add_u32 m0, s39, 66560
  s_add_u32 s38, s48, 4096
  buffer_load_dwordx4 v25, s[24:27], s38 offen lds
  s_add_u32 m0, s39, 67584
  s_add_u32 s38, s48, 8192
  buffer_load_dwordx4 v26, s[24:27], s38 offen lds
  s_add_u32 m0, s39, 68608
  s_add_u32 s38, s48, 12288
  buffer_load_dwordx4 v27, s[24:27], s38 offen lds
  s_add_u32 m0, s39, 98304
  s_add_u32 s38, s42, 1048576
  buffer_load_dwordx4 v13, s[28:31], s38 offen lds
  s_add_u32 m0, s39, 99328
  s_add_u32 s38, s42, 1081344
  buffer_load_dwordx4 v13, s[28:31], s38 offen lds
  s_add_u32 m0, s39, 100352
  s_add_u32 s38, s42, 1114112
  buffer_load_dwordx4 v13, s[28:31], s38 offen lds
  s_add_u32 m0, s39, 101376
  s_add_u32 s38, s42, 1146880
  buffer_load_dwordx4 v13, s[28:31], s38 offen lds
  s_add_u32 m0, s39, 131072
  s_add_u32 s38, s48, 256
  buffer_load_dwordx4 v24, s[24:27], s38 offen lds
  s_add_u32 m0, s39, 132096
  s_add_u32 s38, s48, 4352
  buffer_load_dwordx4 v25, s[24:27], s38 offen lds
  s_add_u32 m0, s39, 133120
  s_add_u32 s38, s48, 8448
  buffer_load_dwordx4 v26, s[24:27], s38 offen lds
  s_add_u32 m0, s39, 134144
  s_add_u32 s38, s48, 12544
  buffer_load_dwordx4 v27, s[24:27], s38 offen lds
  s_add_u32 m0, s45, s41
  s_add_u32 s38, s45, 32768
  buffer_load_dwordx4 v10, s[16:19], s40 offen offset:0 nt lds
  buffer_load_dwordx4 v11, s[16:19], s40 offen offset:1024 nt lds
  s_add_u32 m0, m0, 16384
  s_cmp_ge_u32 s38, 163840
  buffer_load_dwordx4 v12, s[20:23], s40 offen offset:0 nt lds
  buffer_load_dwordx4 v12, s[20:23], s40 offen offset:1024 nt lds
  s_cselect_b32 s45, 0, s38
  s_add_u32 s40, s40, 16384
  v_lshrrev_b32 v2, 2, v1
  v_and_b32 v2, 3, v2
  v_and_b32 v3, 3, v1
  v_lshlrev_b32 v3, 3, v3
  v_bfe_u32 v4, v1, 4, 1
  v_lshl_add_u32 v3, v4, 5, v3
  v_lshl_add_u32 v3, v2, 8, v3
  s_lshl_b32 s3, s43, 1
  v_xor_b32 v4, s3, v2
  v_xor_b32 v4, 0, v4
  v_lshl_add_u32 v4, v4, 6, v3
  v_lshl_add_u32 v20, v5, 11, v4
  v_add_u32 v20, 0x8000, v20
  v_add_u32 v22, 0x10000, v20
  v_xor_b32 v4, s3, v2
  v_xor_b32 v4, 1, v4
  v_lshl_add_u32 v4, v4, 6, v3
  v_lshl_add_u32 v21, v5, 11, v4
  v_add_u32 v21, 0x8000, v21
  v_add_u32 v23, 0x10000, v21
  v_and_b32 v4, 15, v1
  v_xor_b32 v4, v4, v5
  v_lshlrev_b32 v4, 4, v4
  v_and_b32 v14, 31, v1
  v_lshl_add_u32 v14, v14, 8, v4
  s_lshl_b32 s3, s44, 13
  s_add_u32 s3, s3, 0x10000
  v_xor_b32 v32, 0, v14
  v_add_u32 v32, s3, v32
  v_xor_b32 v33, 32, v14
  v_add_u32 v33, s3, v33
  v_xor_b32 v34, 64, v14
  v_add_u32 v34, s3, v34
  v_xor_b32 v35, 96, v14
  v_add_u32 v35, s3, v35
  v_xor_b32 v36, 128, v14
  v_add_u32 v36, s3, v36
  v_xor_b32 v37, 160, v14
  v_add_u32 v37, s3, v37
  v_xor_b32 v38, 192, v14
  v_add_u32 v38, s3, v38
  v_xor_b32 v39, 224, v14
  v_add_u32 v39, s3, v39
  v_mov_b32 v176, 0
  v_mov_b32 v177, 0
  v_mov_b32 v178, 0
  v_mov_b32 v179, 0
  v_mov_b32 v180, 0
  v_mov_b32 v181, 0
  v_mov_b32 v182, 0
  v_mov_b32 v183, 0
  v_mov_b32 v184, 0
  v_mov_b32 v185, 0
  v_mov_b32 v186, 0
  v_mov_b32 v187, 0
  v_mov_b32 v188, 0
  v_mov_b32 v189, 0
  v_mov_b32 v190, 0
  v_mov_b32 v191, 0
  v_mov_b32 v192, 0
  v_mov_b32 v193, 0
  v_mov_b32 v194, 0
  v_mov_b32 v195, 0
  v_mov_b32 v196, 0
  v_mov_b32 v197, 0
  v_mov_b32 v198, 0
  v_mov_b32 v199, 0
  v_mov_b32 v200, 0
  v_mov_b32 v201, 0
  v_mov_b32 v202, 0
  v_mov_b32 v203, 0
  v_mov_b32 v204, 0
  v_mov_b32 v205, 0
  v_mov_b32 v206, 0
  v_mov_b32 v207, 0
  s_waitcnt vmcnt(12)
  s_barrier
  ds_read_b128 v[40:43], v32
  ds_read_b64_tr_b16 v[160:161], v20 offset:0
  ds_read_b64_tr_b16 v[162:163], v20 offset:1024
  ds_read_b64_tr_b16 v[164:165], v21 offset:0
  ds_read_b64_tr_b16 v[166:167], v21 offset:1024
  s_waitcnt lgkmcnt(2)
  v_mfma_f32_32x32x16_bf16 v[176:191], v[160:163], v[40:43], v[176:191]
  s_waitcnt lgkmcnt(0)
  v_mfma_f32_32x32x16_bf16 v[192:207], v[164:167], v[40:43], v[192:207]
  ds_read_b128 v[44:47], v33
  ds_read_b64_tr_b16 v[168:169], v20 offset:4096
  ds_read_b64_tr_b16 v[170:171], v20 offset:5120
  ds_read_b64_tr_b16 v[172:173], v21 offset:4096
  ds_read_b64_tr_b16 v[174:175], v21 offset:5120
  s_waitcnt lgkmcnt(2)
  v_mfma_f32_32x32x16_bf16 v[176:191], v[168:171], v[44:47], v[176:191]
  s_waitcnt lgkmcnt(0)
  v_mfma_f32_32x32x16_bf16 v[192:207], v[172:175], v[44:47], v[192:207]
  ds_read_b128 v[40:43], v34
  ds_read_b64_tr_b16 v[160:161], v20 offset:8192
  ds_read_b64_tr_b16 v[162:163], v20 offset:9216
  ds_read_b64_tr_b16 v[164:165], v21 offset:8192
  ds_read_b64_tr_b16 v[166:167], v21 offset:9216
  s_waitcnt lgkmcnt(2)
  v_mfma_f32_32x32x16_bf16 v[176:191], v[160:163], v[40:43], v[176:191]
  s_waitcnt lgkmcnt(0)
  v_mfma_f32_32x32x16_bf16 v[192:207], v[164:167], v[40:43], v[192:207]
  ds_read_b128 v[44:47], v35
  ds_read_b64_tr_b16 v[168:169], v20 offset:12288
  ds_read_b64_tr_b16 v[170:171], v20 offset:13312
  ds_read_b64_tr_b16 v[172:173], v21 offset:12288
  ds_read_b64_tr_b16 v[174:175], v21 offset:13312
  s_waitcnt lgkmcnt(2)
  v_mfma_f32_32x32x16_bf16 v[176:191], v[168:171], v[44:47], v[176:191]
  s_waitcnt lgkmcnt(0)
  v_mfma_f32_32x32x16_bf16 v[192:207], v[172:175], v[44:47], v[192:207]
  ds_read_b128 v[40:43], v36
  ds_read_b64_tr_b16 v[160:161], v20 offset:16384
  ds_read_b64_tr_b16 v[162:163], v20 offset:17408
  ds_read_b64_tr_b16 v[164:165], v21 offset:16384
  ds_read_b64_tr_b16 v[166:167], v21 offset:17408
  s_waitcnt lgkmcnt(2)
  v_mfma_f32_32x32x16_bf16 v[176:191], v[160:163], v[40:43], v[176:191]
  s_waitcnt lgkmcnt(0)
  v_mfma_f32_32x32x16_bf16 v[192:207], v[164:167], v[40:43], v[192:207]
  ds_read_b128 v[44:47], v37
  ds_read_b64_tr_b16 v[168:169], v20 offset:20480
  ds_read_b64_tr_b16 v[170:171], v20 offset:21504
  ds_read_b64_tr_b16 v[172:173], v21 offset:20480
  ds_read_b64_tr_b16 v[174:175], v21 offset:21504
  s_waitcnt lgkmcnt(2)
  v_mfma_f32_32x32x16_bf16 v[176:191], v[168:171], v[44:47], v[176:191]
  s_waitcnt lgkmcnt(0)
  v_mfma_f32_32x32x16_bf16 v[192:207], v[172:175], v[44:47], v[192:207]
  ds_read_b128 v[40:43], v38
  ds_read_b64_tr_b16 v[160:161], v20 offset:24576
  ds_read_b64_tr_b16 v[162:163], v20 offset:25600
  ds_read_b64_tr_b16 v[164:165], v21 offset:24576
  ds_read_b64_tr_b16 v[166:167], v21 offset:25600
  s_waitcnt lgkmcnt(2)
  v_mfma_f32_32x32x16_bf16 v[176:191], v[160:163], v[40:43], v[176:191]
  s_waitcnt lgkmcnt(0)
  v_mfma_f32_32x32x16_bf16 v[192:207], v[164:167], v[40:43], v[192:207]
  ds_read_b128 v[44:47], v39
  ds_read_b64_tr_b16 v[168:169], v20 offset:28672
  ds_read_b64_tr_b16 v[170:171], v20 offset:29696
  ds_read_b64_tr_b16 v[172:173], v21 offset:28672
  ds_read_b64_tr_b16 v[174:175], v21 offset:29696
  s_waitcnt lgkmcnt(2)
  v_mfma_f32_32x32x16_bf16 v[176:191], v[168:171], v[44:47], v[176:191]
  s_waitcnt lgkmcnt(0)
  v_mfma_f32_32x32x16_bf16 v[192:207], v[172:175], v[44:47], v[192:207]
  v_xor_b32 v32, 0x30000, v32
  v_xor_b32 v33, 0x30000, v33
  v_xor_b32 v34, 0x30000, v34
  v_xor_b32 v35, 0x30000, v35
  v_xor_b32 v36, 0x30000, v36
  v_xor_b32 v37, 0x30000, v37
  v_xor_b32 v38, 0x30000, v38
  v_xor_b32 v39, 0x30000, v39
  s_barrier
  s_add_u32 m0, s39, 32768
  s_add_u32 s38, s42, 2097152
  buffer_load_dwordx4 v13, s[28:31], s38 offen lds
  s_add_u32 m0, s39, 33792
  s_add_u32 s38, s42, 2129920
  buffer_load_dwordx4 v13, s[28:31], s38 offen lds
  s_add_u32 m0, s39, 34816
  s_add_u32 s38, s42, 2162688
  buffer_load_dwordx4 v13, s[28:31], s38 offen lds
  s_add_u32 m0, s39, 35840
  s_add_u32 s38, s42, 2195456
  buffer_load_dwordx4 v13, s[28:31], s38 offen lds
  s_add_u32 m0, s39, 65536
  s_add_u32 s38, s48, 512
  buffer_load_dwordx4 v24, s[24:27], s38 offen lds
  s_add_u32 m0, s39, 66560
  s_add_u32 s38, s48, 4608
  buffer_load_dwordx4 v25, s[24:27], s38 offen lds
  s_add_u32 m0, s39, 67584
  s_add_u32 s38, s48, 8704
  buffer_load_dwordx4 v26, s[24:27], s38 offen lds
  s_add_u32 m0, s39, 68608
  s_add_u32 s38, s48, 12800
  buffer_load_dwordx4 v27, s[24:27], s38 offen lds
  s_waitcnt vmcnt(12)
  s_barrier
  ds_read_b128 v[40:43], v32
  ds_read_b64_tr_b16 v[160:161], v22 offset:0
  ds_read_b64_tr_b16 v[162:163], v22 offset:1024
  ds_read_b64_tr_b16 v[164:165], v23 offset:0
  ds_read_b64_tr_b16 v[166:167], v23 offset:1024
  s_waitcnt lgkmcnt(2)
  v_mfma_f32_32x32x16_bf16 v[176:191], v[160:163], v[40:43], v[176:191]
  s_waitcnt lgkmcnt(0)
  v_mfma_f32_32x32x16_bf16 v[192:207], v[164:167], v[40:43], v[192:207]
  ds_read_b128 v[44:47], v33
  ds_read_b64_tr_b16 v[168:169], v22 offset:4096
  ds_read_b64_tr_b16 v[170:171], v22 offset:5120
  ds_read_b64_tr_b16 v[172:173], v23 offset:4096
  ds_read_b64_tr_b16 v[174:175], v23 offset:5120
  s_waitcnt lgkmcnt(2)
  v_mfma_f32_32x32x16_bf16 v[176:191], v[168:171], v[44:47], v[176:191]
  s_waitcnt lgkmcnt(0)
  v_mfma_f32_32x32x16_bf16 v[192:207], v[172:175], v[44:47], v[192:207]
  ds_read_b128 v[40:43], v34
  ds_read_b64_tr_b16 v[160:161], v22 offset:8192
  ds_read_b64_tr_b16 v[162:163], v22 offset:9216
  ds_read_b64_tr_b16 v[164:165], v23 offset:8192
  ds_read_b64_tr_b16 v[166:167], v23 offset:9216
  s_waitcnt lgkmcnt(2)
  v_mfma_f32_32x32x16_bf16 v[176:191], v[160:163], v[40:43], v[176:191]
  s_waitcnt lgkmcnt(0)
  v_mfma_f32_32x32x16_bf16 v[192:207], v[164:167], v[40:43], v[192:207]
  ds_read_b128 v[44:47], v35
  ds_read_b64_tr_b16 v[168:169], v22 offset:12288
  ds_read_b64_tr_b16 v[170:171], v22 offset:13312
  ds_read_b64_tr_b16 v[172:173], v23 offset:12288
  ds_read_b64_tr_b16 v[174:175], v23 offset:13312
  s_waitcnt lgkmcnt(2)
  v_mfma_f32_32x32x16_bf16 v[176:191], v[168:171], v[44:47], v[176:191]
  s_waitcnt lgkmcnt(0)
  v_mfma_f32_32x32x16_bf16 v[192:207], v[172:175], v[44:47], v[192:207]
  ds_read_b128 v[40:43], v36
  ds_read_b64_tr_b16 v[160:161], v22 offset:16384
  ds_read_b64_tr_b16 v[162:163], v22 offset:17408
  ds_read_b64_tr_b16 v[164:165], v23 offset:16384
  ds_read_b64_tr_b16 v[166:167], v23 offset:17408
  s_waitcnt lgkmcnt(2)
  v_mfma_f32_32x32x16_bf16 v[176:191], v[160:163], v[40:43], v[176:191]
  s_waitcnt lgkmcnt(0)
  v_mfma_f32_32x32x16_bf16 v[192:207], v[164:167], v[40:43], v[192:207]
  ds_read_b128 v[44:47], v37
  ds_read_b64_tr_b16 v[168:169], v22 offset:20480
  ds_read_b64_tr_b16 v[170:171], v22 offset:21504
  ds_read_b64_tr_b16 v[172:173], v23 offset:20480
  ds_read_b64_tr_b16 v[174:175], v23 offset:21504
  s_waitcnt lgkmcnt(2)
  v_mfma_f32_32x32x16_bf16 v[176:191], v[168:171], v[44:47], v[176:191]
  s_waitcnt lgkmcnt(0)
  v_mfma_f32_32x32x16_bf16 v[192:207], v[172:175], v[44:47], v[192:207]
  ds_read_b128 v[40:43], v38
  ds_read_b64_tr_b16 v[160:161], v22 offset:24576
  ds_read_b64_tr_b16 v[162:163], v22 offset:25600
  ds_read_b64_tr_b16 v[164:165], v23 offset:24576
  ds_read_b64_tr_b16 v[166:167], v23 offset:25600
  s_waitcnt lgkmcnt(2)
  v_mfma_f32_32x32x16_bf16 v[176:191], v[160:163], v[40:43], v[176:191]
  s_waitcnt lgkmcnt(0)
  v_mfma_f32_32x32x16_bf16 v[192:207], v[164:167], v[40:43], v[192:207]
  ds_read_b128 v[44:47], v39
  ds_read_b64_tr_b16 v[168:169], v22 offset:28672
  ds_read_b64_tr_b16 v[170:171], v22 offset:29696
  ds_read_b64_tr_b16 v[172:173], v23 offset:28672
  ds_read_b64_tr_b16 v[174:175], v23 offset:29696
  s_waitcnt lgkmcnt(2)
  v_mfma_f32_32x32x16_bf16 v[176:191], v[168:171], v[44:47], v[176:191]
  s_waitcnt lgkmcnt(0)
  v_mfma_f32_32x32x16_bf16 v[192:207], v[172:175], v[44:47], v[192:207]
  v_xor_b32 v32, 0x30000, v32
  v_xor_b32 v33, 0x30000, v33
  v_xor_b32 v34, 0x30000, v34
  v_xor_b32 v35, 0x30000, v35
  v_xor_b32 v36, 0x30000, v36
  v_xor_b32 v37, 0x30000, v37
  v_xor_b32 v38, 0x30000, v38
  v_xor_b32 v39, 0x30000, v39
  s_barrier
  s_add_u32 m0, s39, 98304
  s_add_u32 s38, s42, 3145728
  buffer_load_dwordx4 v13, s[28:31], s38 offen lds
  s_add_u32 m0, s39, 99328
  s_add_u32 s38, s42, 3178496
  buffer_load_dwordx4 v13, s[28:31], s38 offen lds
  s_add_u32 m0, s39, 100352
  s_add_u32 s38, s42, 3211264
  buffer_load_dwordx4 v13, s[28:31], s38 offen lds
  s_add_u32 m0, s39, 101376
  s_add_u32 s38, s42, 3244032
  buffer_load_dwordx4 v13, s[28:31], s38 offen lds
  s_add_u32 m0, s39, 131072
  s_add_u32 s38, s48, 768
  buffer_load_dwordx4 v24, s[24:27], s38 offen lds
  s_add_u32 m0, s39, 132096
  s_add_u32 s38, s48, 4864
  buffer_load_dwordx4 v25, s[24:27], s38 offen lds
  s_add_u32 m0, s39, 133120
  s_add_u32 s38, s48, 8960
  buffer_load_dwordx4 v26, s[24:27], s38 offen lds
  s_add_u32 m0, s39, 134144
  s_add_u32 s38, s48, 13056
  buffer_load_dwordx4 v27, s[24:27], s38 offen lds
  s_waitcnt vmcnt(8)
  s_barrier
  ds_read_b128 v[40:43], v32
  ds_read_b64_tr_b16 v[160:161], v20 offset:0
  ds_read_b64_tr_b16 v[162:163], v20 offset:1024
  ds_read_b64_tr_b16 v[164:165], v21 offset:0
  ds_read_b64_tr_b16 v[166:167], v21 offset:1024
  s_waitcnt lgkmcnt(2)
  v_mfma_f32_32x32x16_bf16 v[176:191], v[160:163], v[40:43], v[176:191]
  s_waitcnt lgkmcnt(0)
  v_mfma_f32_32x32x16_bf16 v[192:207], v[164:167], v[40:43], v[192:207]
  ds_read_b128 v[44:47], v33
  ds_read_b64_tr_b16 v[168:169], v20 offset:4096
  ds_read_b64_tr_b16 v[170:171], v20 offset:5120
  ds_read_b64_tr_b16 v[172:173], v21 offset:4096
  ds_read_b64_tr_b16 v[174:175], v21 offset:5120
  s_waitcnt lgkmcnt(2)
  v_mfma_f32_32x32x16_bf16 v[176:191], v[168:171], v[44:47], v[176:191]
  s_waitcnt lgkmcnt(0)
  v_mfma_f32_32x32x16_bf16 v[192:207], v[172:175], v[44:47], v[192:207]
  ds_read_b128 v[40:43], v34
  ds_read_b64_tr_b16 v[160:161], v20 offset:8192
  ds_read_b64_tr_b16 v[162:163], v20 offset:9216
  ds_read_b64_tr_b16 v[164:165], v21 offset:8192
  ds_read_b64_tr_b16 v[166:167], v21 offset:9216
  s_waitcnt lgkmcnt(2)
  v_mfma_f32_32x32x16_bf16 v[176:191], v[160:163], v[40:43], v[176:191]
  s_waitcnt lgkmcnt(0)
  v_mfma_f32_32x32x16_bf16 v[192:207], v[164:167], v[40:43], v[192:207]
  ds_read_b128 v[44:47], v35
  ds_read_b64_tr_b16 v[168:169], v20 offset:12288
  ds_read_b64_tr_b16 v[170:171], v20 offset:13312
  ds_read_b64_tr_b16 v[172:173], v21 offset:12288
  ds_read_b64_tr_b16 v[174:175], v21 offset:13312
  s_waitcnt lgkmcnt(2)
  v_mfma_f32_32x32x16_bf16 v[176:191], v[168:171], v[44:47], v[176:191]
  s_waitcnt lgkmcnt(0)
  v_mfma_f32_32x32x16_bf16 v[192:207], v[172:175], v[44:47], v[192:207]
  ds_read_b128 v[40:43], v36
  ds_read_b64_tr_b16 v[160:161], v20 offset:16384
  ds_read_b64_tr_b16 v[162:163], v20 offset:17408
  ds_read_b64_tr_b16 v[164:165], v21 offset:16384
  ds_read_b64_tr_b16 v[166:167], v21 offset:17408
  s_waitcnt lgkmcnt(2)
  v_mfma_f32_32x32x16_bf16 v[176:191], v[160:163], v[40:43], v[176:191]
  s_waitcnt lgkmcnt(0)
  v_mfma_f32_32x32x16_bf16 v[192:207], v[164:167], v[40:43], v[192:207]
  ds_read_b128 v[44:47], v37
  ds_read_b64_tr_b16 v[168:169], v20 offset:20480
  ds_read_b64_tr_b16 v[170:171], v20 offset:21504
  ds_read_b64_tr_b16 v[172:173], v21 offset:20480
  ds_read_b64_tr_b16 v[174:175], v21 offset:21504
  s_waitcnt lgkmcnt(2)
  v_mfma_f32_32x32x16_bf16 v[176:191], v[168:171], v[44:47], v[176:191]
  s_waitcnt lgkmcnt(0)
  v_mfma_f32_32x32x16_bf16 v[192:207], v[172:175], v[44:47], v[192:207]
  ds_read_b128 v[40:43], v38
  ds_read_b64_tr_b16 v[160:161], v20 offset:24576
  ds_read_b64_tr_b16 v[162:163], v20 offset:25600
  ds_read_b64_tr_b16 v[164:165], v21 offset:24576
  ds_read_b64_tr_b16 v[166:167], v21 offset:25600
  s_waitcnt lgkmcnt(2)
  v_mfma_f32_32x32x16_bf16 v[176:191], v[160:163], v[40:43], v[176:191]
  s_waitcnt lgkmcnt(0)
  v_mfma_f32_32x32x16_bf16 v[192:207], v[164:167], v[40:43], v[192:207]
  ds_read_b128 v[44:47], v39
  ds_read_b64_tr_b16 v[168:169], v20 offset:28672
  ds_read_b64_tr_b16 v[170:171], v20 offset:29696
  ds_read_b64_tr_b16 v[172:173], v21 offset:28672
  ds_read_b64_tr_b16 v[174:175], v21 offset:29696
  s_waitcnt lgkmcnt(2)
  v_mfma_f32_32x32x16_bf16 v[176:191], v[168:171], v[44:47], v[176:191]
  s_waitcnt lgkmcnt(0)
  v_mfma_f32_32x32x16_bf16 v[192:207], v[172:175], v[44:47], v[192:207]
  v_xor_b32 v32, 0x30000, v32
  v_xor_b32 v33, 0x30000, v33
  v_xor_b32 v34, 0x30000, v34
  v_xor_b32 v35, 0x30000, v35
  v_xor_b32 v36, 0x30000, v36
  v_xor_b32 v37, 0x30000, v37
  v_xor_b32 v38, 0x30000, v38
  v_xor_b32 v39, 0x30000, v39
  s_barrier
  s_add_u32 m0, s45, s41
  s_add_u32 s38, s45, 32768
  buffer_load_dwordx4 v10, s[16:19], s40 offen offset:0 nt lds
  buffer_load_dwordx4 v11, s[16:19], s40 offen offset:1024 nt lds
  s_add_u32 m0, m0, 16384
  s_cmp_ge_u32 s38, 163840
  buffer_load_dwordx4 v12, s[20:23], s40 offen offset:0 nt lds
  buffer_load_dwordx4 v12, s[20:23], s40 offen offset:1024 nt lds
  s_cselect_b32 s45, 0, s38
  s_add_u32 s40, s40, 16384
  s_add_u32 m0, s45, s41
  s_add_u32 s38, s45, 32768
  buffer_load_dwordx4 v10, s[16:19], s40 offen offset:0 nt lds
  buffer_load_dwordx4 v11, s[16:19], s40 offen offset:1024 nt lds
  s_add_u32 m0, m0, 16384
  s_cmp_ge_u32 s38, 163840
  buffer_load_dwordx4 v12, s[20:23], s40 offen offset:0 nt lds
  buffer_load_dwordx4 v12, s[20:23], s40 offen offset:1024 nt lds
  s_cselect_b32 s45, 0, s38
  s_add_u32 s40, s40, 16384
  s_waitcnt vmcnt(8)
  s_barrier
  ds_read_b128 v[40:43], v32
  ds_read_b64_tr_b16 v[160:161], v22 offset:0
  ds_read_b64_tr_b16 v[162:163], v22 offset:1024
  ds_read_b64_tr_b16 v[164:165], v23 offset:0
  ds_read_b64_tr_b16 v[166:167], v23 offset:1024
  s_waitcnt lgkmcnt(2)
  v_mfma_f32_32x32x16_bf16 v[176:191], v[160:163], v[40:43], v[176:191]
  s_waitcnt lgkmcnt(0)
  v_mfma_f32_32x32x16_bf16 v[192:207], v[164:167], v[40:43], v[192:207]
  ds_read_b128 v[44:47], v33
  ds_read_b64_tr_b16 v[168:169], v22 offset:4096
  ds_read_b64_tr_b16 v[170:171], v22 offset:5120
  ds_read_b64_tr_b16 v[172:173], v23 offset:4096
  ds_read_b64_tr_b16 v[174:175], v23 offset:5120
  s_waitcnt lgkmcnt(2)
  v_mfma_f32_32x32x16_bf16 v[176:191], v[168:171], v[44:47], v[176:191]
  s_waitcnt lgkmcnt(0)
  v_mfma_f32_32x32x16_bf16 v[192:207], v[172:175], v[44:47], v[192:207]
  ds_read_b128 v[40:43], v34
  ds_read_b64_tr_b16 v[160:161], v22 offset:8192
  ds_read_b64_tr_b16 v[162:163], v22 offset:9216
  ds_read_b64_tr_b16 v[164:165], v23 offset:8192
  ds_read_b64_tr_b16 v[166:167], v23 offset:9216
  s_waitcnt lgkmcnt(2)
  v_mfma_f32_32x32x16_bf16 v[176:191], v[160:163], v[40:43], v[176:191]
  s_waitcnt lgkmcnt(0)
  v_mfma_f32_32x32x16_bf16 v[192:207], v[164:167], v[40:43], v[192:207]
  ds_read_b128 v[44:47], v35
  ds_read_b64_tr_b16 v[168:169], v22 offset:12288
  ds_read_b64_tr_b16 v[170:171], v22 offset:13312
  ds_read_b64_tr_b16 v[172:173], v23 offset:12288
  ds_read_b64_tr_b16 v[174:175], v23 offset:13312
  s_waitcnt lgkmcnt(2)
  v_mfma_f32_32x32x16_bf16 v[176:191], v[168:171], v[44:47], v[176:191]
  s_waitcnt lgkmcnt(0)
  v_mfma_f32_32x32x16_bf16 v[192:207], v[172:175], v[44:47], v[192:207]
  ds_read_b128 v[40:43], v36
  ds_read_b64_tr_b16 v[160:161], v22 offset:16384
  ds_read_b64_tr_b16 v[162:163], v22 offset:17408
  ds_read_b64_tr_b16 v[164:165], v23 offset:16384
  ds_read_b64_tr_b16 v[166:167], v23 offset:17408
  s_waitcnt lgkmcnt(2)
  v_mfma_f32_32x32x16_bf16 v[176:191], v[160:163], v[40:43], v[176:191]
  s_waitcnt lgkmcnt(0)
  v_mfma_f32_32x32x16_bf16 v[192:207], v[164:167], v[40:43], v[192:207]
  ds_read_b128 v[44:47], v37
  ds_read_b64_tr_b16 v[168:169], v22 offset:20480
  ds_read_b64_tr_b16 v[170:171], v22 offset:21504
  ds_read_b64_tr_b16 v[172:173], v23 offset:20480
  ds_read_b64_tr_b16 v[174:175], v23 offset:21504
  s_waitcnt lgkmcnt(2)
  v_mfma_f32_32x32x16_bf16 v[176:191], v[168:171], v[44:47], v[176:191]
  s_waitcnt lgkmcnt(0)
  v_mfma_f32_32x32x16_bf16 v[192:207], v[172:175], v[44:47], v[192:207]
  ds_read_b128 v[40:43], v38
  ds_read_b64_tr_b16 v[160:161], v22 offset:24576
  ds_read_b64_tr_b16 v[162:163], v22 offset:25600
  ds_read_b64_tr_b16 v[164:165], v23 offset:24576
  ds_read_b64_tr_b16 v[166:167], v23 offset:25600
  s_waitcnt lgkmcnt(2)
  v_mfma_f32_32x32x16_bf16 v[176:191], v[160:163], v[40:43], v[176:191]
  s_waitcnt lgkmcnt(0)
  v_mfma_f32_32x32x16_bf16 v[192:207], v[164:167], v[40:43], v[192:207]
  ds_read_b128 v[44:47], v39
  ds_read_b64_tr_b16 v[168:169], v22 offset:28672
  ds_read_b64_tr_b16 v[170:171], v22 offset:29696
  ds_read_b64_tr_b16 v[172:173], v23 offset:28672
  ds_read_b64_tr_b16 v[174:175], v23 offset:29696
  s_waitcnt lgkmcnt(2)
  v_mfma_f32_32x32x16_bf16 v[176:191], v[168:171], v[44:47], v[176:191]
  s_waitcnt lgkmcnt(0)
  v_mfma_f32_32x32x16_bf16 v[192:207], v[172:175], v[44:47], v[192:207]
  v_xor_b32 v32, 0x30000, v32
  v_xor_b32 v33, 0x30000, v33
  v_xor_b32 v34, 0x30000, v34
  v_xor_b32 v35, 0x30000, v35
  v_xor_b32 v36, 0x30000, v36
  v_xor_b32 v37, 0x30000, v37
  v_xor_b32 v38, 0x30000, v38
  v_xor_b32 v39, 0x30000, v39
  v_xor_b32 v4, 0, v2
  v_lshl_add_u32 v4, v4, 6, v3
  v_lshl_add_u32 v16, v5, 10, v4
  v_add_u32 v16, 16384, v16
  v_xor_b32 v4, 1, v2
  v_lshl_add_u32 v4, v4, 6, v3
  v_lshl_add_u32 v17, v5, 10, v4
  v_add_u32 v17, 16384, v17
  v_xor_b32 v4, 2, v2
  v_lshl_add_u32 v4, v4, 6, v3
  v_lshl_add_u32 v18, v5, 10, v4
  v_add_u32 v18, 16384, v18
  v_xor_b32 v4, 3, v2
  v_lshl_add_u32 v4, v4, 6, v3
  v_lshl_add_u32 v19, v5, 10, v4
  v_add_u32 v19, 16384, v19
  v_and_b32 v2, 15, v1
  v_xor_b32 v2, v2, v5
  v_lshlrev_b32 v2, 4, v2
  v_and_b32 v3, 31, v1
  v_lshl_add_u32 v14, v3, 8, v2
  s_nop 7
  s_nop 7
  v_cvt_pk_bf16_f32 v64, v176, v177
  v_cvt_pk_bf16_f32 v65, v178, v179
  v_cvt_pk_bf16_f32 v66, v180, v181
  v_cvt_pk_bf16_f32 v67, v182, v183
  s_nop 1
  v_permlane32_swap_b32 v64, v66
  v_permlane32_swap_b32 v65, v67
  v_cvt_pk_bf16_f32 v68, v184, v185
  v_cvt_pk_bf16_f32 v69, v186, v187
  v_cvt_pk_bf16_f32 v70, v188, v189
  v_cvt_pk_bf16_f32 v71, v190, v191
  s_nop 1
  v_permlane32_swap_b32 v68, v70
  v_permlane32_swap_b32 v69, v71
  v_cvt_pk_bf16_f32 v72, v192, v193
  v_cvt_pk_bf16_f32 v73, v194, v195
  v_cvt_pk_bf16_f32 v74, v196, v197
  v_cvt_pk_bf16_f32 v75, v198, v199
  s_nop 1
  v_permlane32_swap_b32 v72, v74
  v_permlane32_swap_b32 v73, v75
  v_cvt_pk_bf16_f32 v76, v200, v201
  v_cvt_pk_bf16_f32 v77, v202, v203
  v_cvt_pk_bf16_f32 v78, v204, v205
  v_cvt_pk_bf16_f32 v79, v206, v207
  s_nop 1
  v_permlane32_swap_b32 v76, v78
  v_permlane32_swap_b32 v77, v79
  v_lshlrev_b32 v2, 4, v1
  s_lshl_b32 s3, s44, 13
  s_add_u32 s3, s3, 131072
  v_add_u32 v2, s3, v2
  s_lshl_b32 s3, s43, 12
  v_add_u32 v3, s3, v2
  s_barrier
  ds_write_b128 v3, v[64:67] offset:0
  ds_write_b128 v3, v[68:71] offset:1024
  ds_write_b128 v3, v[72:75] offset:2048
  ds_write_b128 v3, v[76:79] offset:3072
  s_waitcnt lgkmcnt(0)
  s_barrier
  ds_read_b128 v[32:35], v2 offset:0
  ds_read_b128 v[36:39], v2 offset:1024
  ds_read_b128 v[40:43], v2 offset:2048
  ds_read_b128 v[44:47], v2 offset:3072
  ds_read_b128 v[48:51], v2 offset:4096
  ds_read_b128 v[52:55], v2 offset:5120
  ds_read_b128 v[56:59], v2 offset:6144
  ds_read_b128 v[60:63], v2 offset:7168
  v_mov_b32 v112, 0
  v_mov_b32 v113, 0
  v_mov_b32 v114, 0
  v_mov_b32 v115, 0
  v_mov_b32 v116, 0
  v_mov_b32 v117, 0
  v_mov_b32 v118, 0
  v_mov_b32 v119, 0
  v_mov_b32 v120, 0
  v_mov_b32 v121, 0
  v_mov_b32 v122, 0
  v_mov_b32 v123, 0
  v_mov_b32 v124, 0
  v_mov_b32 v125, 0
  v_mov_b32 v126, 0
  v_mov_b32 v127, 0
  v_mov_b32 v128, 0
  v_mov_b32 v129, 0
  v_mov_b32 v130, 0
  v_mov_b32 v131, 0
  v_mov_b32 v132, 0
  v_mov_b32 v133, 0
  v_mov_b32 v134, 0
  v_mov_b32 v135, 0
  v_mov_b32 v136, 0
  v_mov_b32 v137, 0
  v_mov_b32 v138, 0
  v_mov_b32 v139, 0
  v_mov_b32 v140, 0
  v_mov_b32 v141, 0
  v_mov_b32 v142, 0
  v_mov_b32 v143, 0
  v_mov_b32 v144, 0
  v_mov_b32 v145, 0
  v_mov_b32 v146, 0
  v_mov_b32 v147, 0
  v_mov_b32 v148, 0
  v_mov_b32 v149, 0
  v_mov_b32 v150, 0
  v_mov_b32 v151, 0
  v_mov_b32 v152, 0
  v_mov_b32 v153, 0
  v_mov_b32 v154, 0
  v_mov_b32 v155, 0
  v_mov_b32 v156, 0
  v_mov_b32 v157, 0
  v_mov_b32 v158, 0
  v_mov_b32 v159, 0
  v_mov_b32 v160, 0
  v_mov_b32 v161, 0
  v_mov_b32 v162, 0
  v_mov_b32 v163, 0
  v_mov_b32 v164, 0
  v_mov_b32 v165, 0
  v_mov_b32 v166, 0
  v_mov_b32 v167, 0
  v_mov_b32 v168, 0
  v_mov_b32 v169, 0
  v_mov_b32 v170, 0
  v_mov_b32 v171, 0
  v_mov_b32 v172, 0
  v_mov_b32 v173, 0
  v_mov_b32 v174, 0
  v_mov_b32 v175, 0
  v_mov_b32 v6, 0xff800000
  v_mov_b32 v7, 0
  s_mov_b32 s3, 0
  s_lshl_b32 s46, s43, 15
  s_waitcnt lgkmcnt(0)
  s_cmp_eq_u32 s43, 0
  s_cbranch_scc1 L1_loop
  s_barrier
  s_add_u32 m0, s45, s41
  s_add_u32 s38, s45, 32768
  buffer_load_dwordx4 v10, s[16:19], s40 offen offset:0 nt lds
  buffer_load_dwordx4 v11, s[16:19], s40 offen offset:1024 nt lds
  s_add_u32 m0, m0, 16384
  s_cmp_ge_u32 s38, 163840
  buffer_load_dwordx4 v12, s[20:23], s40 offen offset:0 nt lds
  buffer_load_dwordx4 v12, s[20:23], s40 offen offset:1024 nt lds
  s_cselect_b32 s45, 0, s38
  s_add_u32 s40, s40, 16384
L1_loop:
  v_xor_b32 v20, 0, v14
  v_add_u32 v20, s46, v20
  v_xor_b32 v21, 32, v14
  v_add_u32 v21, s46, v21
  v_xor_b32 v22, 64, v14
  v_add_u32 v22, s46, v22
  v_xor_b32 v23, 96, v14
  v_add_u32 v23, s46, v23
  v_xor_b32 v24, 128, v14
  v_add_u32 v24, s46, v24
  v_xor_b32 v25, 160, v14
  v_add_u32 v25, s46, v25
  v_xor_b32 v26, 192, v14
  v_add_u32 v26, s46, v26
  v_xor_b32 v27, 224, v14
  v_add_u32 v27, s46, v27
  v_add_u32 v28, s46, v16
  v_add_u32 v29, s46, v17
  v_add_u32 v30, s46, v18
  v_add_u32 v31, s46, v19
  s_add_u32 s46, s46, 65536
  s_sub_u32 s38, s46, 163840
  s_cmp_ge_u32 s46, 163840
  s_cselect_b32 s46, s38, s46
  s_waitcnt vmcnt(8)
  s_barrier
  s_add_u32 m0, s45, s41
  s_add_u32 s38, s45, 32768
  buffer_load_dwordx4 v10, s[16:19], s40 offen offset:0 nt lds
  buffer_load_dwordx4 v11, s[16:19], s40 offen offset:1024 nt lds
  s_add_u32 m0, m0, 16384
  s_cmp_ge_u32 s38, 163840
  buffer_load_dwordx4 v12, s[20:23], s40 offen offset:0 nt lds
  buffer_load_dwordx4 v12, s[20:23], s40 offen offset:1024 nt lds
  s_cselect_b32 s45, 0, s38
  s_add_u32 s40, s40, 16384
  ds_read_b128 v[176:179], v20 offset:0
  ds_read_b128 v[180:183], v21 offset:0
  ds_read_b128 v[184:187], v22 offset:0
  ds_read_b128 v[188:191], v23 offset:0
  ds_read_b128 v[192:195], v24 offset:0
  ds_read_b128 v[196:199], v25 offset:0
  ds_read_b128 v[200:203], v26 offset:0
  ds_read_b128 v[204:207], v27 offset:0
  s_waitcnt lgkmcnt(7)
  v_mfma_f32_32x32x16_bf16 v[64:79], v[176:179], v[32:35], 0
  s_waitcnt lgkmcnt(6)
  v_mfma_f32_32x32x16_bf16 v[64:79], v[180:183], v[36:39], v[64:79]
  s_waitcnt lgkmcnt(5)
  v_mfma_f32_32x32x16_bf16 v[64:79], v[184:187], v[40:43], v[64:79]
  s_waitcnt lgkmcnt(4)
  v_mfma_f32_32x32x16_bf16 v[64:79], v[188:191], v[44:47], v[64:79]
  s_waitcnt lgkmcnt(3)
  v_mfma_f32_32x32x16_bf16 v[64:79], v[192:195], v[48:51], v[64:79]
  s_waitcnt lgkmcnt(2)
  v_mfma_f32_32x32x16_bf16 v[64:79], v[196:199], v[52:55], v[64:79]
  s_waitcnt lgkmcnt(1)
  v_mfma_f32_32x32x16_bf16 v[64:79], v[200:203], v[56:59], v[64:79]
  s_waitcnt lgkmcnt(0)
  v_mfma_f32_32x32x16_bf16 v[64:79], v[204:207], v[60:63], v[64:79]
  ds_read_b128 v[176:179], v20 offset:8192
  ds_read_b128 v[180:183], v21 offset:8192
  ds_read_b128 v[184:187], v22 offset:8192
  ds_read_b128 v[188:191], v23 offset:8192
  ds_read_b128 v[192:195], v24 offset:8192
  ds_read_b128 v[196:199], v25 offset:8192
  ds_read_b128 v[200:203], v26 offset:8192
  ds_read_b128 v[204:207], v27 offset:8192
  s_waitcnt lgkmcnt(7)
  v_mfma_f32_32x32x16_bf16 v[80:95], v[176:179], v[32:35], 0
  s_waitcnt lgkmcnt(6)
  v_mfma_f32_32x32x16_bf16 v[80:95], v[180:183], v[36:39], v[80:95]
  s_waitcnt lgkmcnt(5)
  v_mfma_f32_32x32x16_bf16 v[80:95], v[184:187], v[40:43], v[80:95]
  s_waitcnt lgkmcnt(4)
  v_mfma_f32_32x32x16_bf16 v[80:95], v[188:191], v[44:47], v[80:95]
  s_waitcnt lgkmcnt(3)
  v_mfma_f32_32x32x16_bf16 v[80:95], v[192:195], v[48:51], v[80:95]
  s_waitcnt lgkmcnt(2)
  v_mfma_f32_32x32x16_bf16 v[80:95], v[196:199], v[52:55], v[80:95]
  s_waitcnt lgkmcnt(1)
  v_mfma_f32_32x32x16_bf16 v[80:95], v[200:203], v[56:59], v[80:95]
  s_waitcnt lgkmcnt(0)
  v_mfma_f32_32x32x16_bf16 v[80:95], v[204:207], v[60:63], v[80:95]
  s_nop 7
  s_nop 7
  v_max3_f32 v2, v64, v65, v66
  v_max3_f32 v3, v80, v81, v82
  v_max3_f32 v2, v2, v67, v68
  v_max3_f32 v3, v3, v83, v84
  v_max3_f32 v2, v2, v69, v70
  v_max3_f32 v3, v3, v85, v86
  v_max3_f32 v2, v2, v71, v72
  v_max3_f32 v3, v3, v87, v88
  v_max3_f32 v2, v2, v73, v74
  v_max3_f32 v3, v3, v89, v90
  v_max3_f32 v2, v2, v75, v76
  v_max3_f32 v3, v3, v91, v92
  v_max3_f32 v2, v2, v77, v78
  v_max3_f32 v3, v3, v93, v94
  v_max3_f32 v2, v2, v79, v95
  v_max_f32 v2, v2, v3
  v_mov_b32 v3, v2
  s_nop 1
  v_permlane32_swap_b32 v2, v3
  v_max3_f32 v2, v2, v3, v6
  v_sub_f32 v3, v6, v2
  v_mul_f32 v3, s37, v3
  v_exp_f32 v8, v3
  v_mov_b32 v6, v2
  v_mul_f32 v9, s37, v2
  v_fma_f32 v64, v64, s37, -v9
  v_fma_f32 v65, v65, s37, -v9
  v_fma_f32 v66, v66, s37, -v9
  v_fma_f32 v67, v67, s37, -v9
  v_fma_f32 v68, v68, s37, -v9
  v_fma_f32 v69, v69, s37, -v9
  v_fma_f32 v70, v70, s37, -v9
  v_fma_f32 v71, v71, s37, -v9
  v_fma_f32 v72, v72, s37, -v9
  v_fma_f32 v73, v73, s37, -v9
  v_fma_f32 v74, v74, s37, -v9
  v_fma_f32 v75, v75, s37, -v9
  v_fma_f32 v76, v76, s37, -v9
  v_fma_f32 v77, v77, s37, -v9
  v_fma_f32 v78, v78, s37, -v9
  v_fma_f32 v79, v79, s37, -v9
  v_fma_f32 v80, v80, s37, -v9
  v_fma_f32 v81, v81, s37, -v9
  v_fma_f32 v82, v82, s37, -v9
  v_fma_f32 v83, v83, s37, -v9
  v_fma_f32 v84, v84, s37, -v9
  v_fma_f32 v85, v85, s37, -v9
  v_fma_f32 v86, v86, s37, -v9
  v_fma_f32 v87, v87, s37, -v9
  v_fma_f32 v88, v88, s37, -v9
  v_fma_f32 v89, v89, s37, -v9
  v_fma_f32 v90, v90, s37, -v9
  v_fma_f32 v91, v91, s37, -v9
  v_fma_f32 v92, v92, s37, -v9
  v_fma_f32 v93, v93, s37, -v9
  v_fma_f32 v94, v94, s37, -v9
  v_fma_f32 v95, v95, s37, -v9
  v_exp_f32 v64, v64
  v_exp_f32 v65, v65
  v_exp_f32 v66, v66
  v_exp_f32 v67, v67
  v_exp_f32 v68, v68
  v_exp_f32 v69, v69
  v_exp_f32 v70, v70
  v_exp_f32 v71, v71
  v_exp_f32 v72, v72
  v_exp_f32 v73, v73
  v_exp_f32 v74, v74
  v_exp_f32 v75, v75
  v_exp_f32 v76, v76
  v_exp_f32 v77, v77
  v_exp_f32 v78, v78
  v_exp_f32 v79, v79
  v_exp_f32 v80, v80
  v_exp_f32 v81, v81
  v_exp_f32 v82, v82
  v_exp_f32 v83, v83
  v_exp_f32 v84, v84
  v_exp_f32 v85, v85
  v_exp_f32 v86, v86
  v_exp_f32 v87, v87
  v_exp_f32 v88, v88
  v_exp_f32 v89, v89
  v_exp_f32 v90, v90
  v_exp_f32 v91, v91
  v_exp_f32 v92, v92
  v_exp_f32 v93, v93
  v_exp_f32 v94, v94
  v_exp_f32 v95, v95
  v_mul_f32 v7, v7, v8
  v_mov_b32 v2, 0
  v_add_f32 v7, v7, v64
  v_add_f32 v2, v2, v65
  v_add_f32 v7, v7, v66
  v_add_f32 v2, v2, v67
  v_add_f32 v7, v7, v68
  v_add_f32 v2, v2, v69
  v_add_f32 v7, v7, v70
  v_add_f32 v2, v2, v71
  v_add_f32 v7, v7, v72
  v_add_f32 v2, v2, v73
  v_add_f32 v7, v7, v74
  v_add_f32 v2, v2, v75
  v_add_f32 v7, v7, v76
  v_add_f32 v2, v2, v77
  v_add_f32 v7, v7, v78
  v_add_f32 v2, v2, v79
  v_add_f32 v7, v7, v80
  v_add_f32 v2, v2, v81
  v_add_f32 v7, v7, v82
  v_add_f32 v2, v2, v83
  v_add_f32 v7, v7, v84
  v_add_f32 v2, v2, v85
  v_add_f32 v7, v7, v86
  v_add_f32 v2, v2, v87
  v_add_f32 v7, v7, v88
  v_add_f32 v2, v2, v89
  v_add_f32 v7, v7, v90
  v_add_f32 v2, v2, v91
  v_add_f32 v7, v7, v92
  v_add_f32 v2, v2, v93
  v_add_f32 v7, v7, v94
  v_add_f32 v2, v2, v95
  v_add_f32 v7, v7, v2
  v_cvt_pk_bf16_f32 v96, v64, v65
  v_cvt_pk_bf16_f32 v97, v66, v67
  v_cvt_pk_bf16_f32 v98, v68, v69
  v_cvt_pk_bf16_f32 v99, v70, v71
  v_cvt_pk_bf16_f32 v100, v72, v73
  v_cvt_pk_bf16_f32 v101, v74, v75
  v_cvt_pk_bf16_f32 v102, v76, v77
  v_cvt_pk_bf16_f32 v103, v78, v79
  v_cvt_pk_bf16_f32 v104, v80, v81
  v_cvt_pk_bf16_f32 v105, v82, v83
  v_cvt_pk_bf16_f32 v106, v84, v85
  v_cvt_pk_bf16_f32 v107, v86, v87
  v_cvt_pk_bf16_f32 v108, v88, v89
  v_cvt_pk_bf16_f32 v109, v90, v91
  v_cvt_pk_bf16_f32 v110, v92, v93
  v_cvt_pk_bf16_f32 v111, v94, v95
  s_waitcnt vmcnt(8)
  s_barrier
  s_add_u32 m0, s45, s41
  s_add_u32 s38, s45, 32768
  buffer_load_dwordx4 v10, s[16:19], s40 offen offset:0 nt lds
  buffer_load_dwordx4 v11, s[16:19], s40 offen offset:1024 nt lds
  s_add_u32 m0, m0, 16384
  s_cmp_ge_u32 s38, 163840
  buffer_load_dwordx4 v12, s[20:23], s40 offen offset:0 nt lds
  buffer_load_dwordx4 v12, s[20:23], s40 offen offset:1024 nt lds
  s_cselect_b32 s45, 0, s38
  s_add_u32 s40, s40, 16384
  ds_read_b64_tr_b16 v[208:209], v28 offset:0
  ds_read_b64_tr_b16 v[210:211], v28 offset:2048
  ds_read_b64_tr_b16 v[212:213], v29 offset:0
  ds_read_b64_tr_b16 v[214:215], v29 offset:2048
  ds_read_b64_tr_b16 v[216:217], v30 offset:0
  ds_read_b64_tr_b16 v[218:219], v30 offset:2048
  ds_read_b64_tr_b16 v[220:221], v31 offset:0
  ds_read_b64_tr_b16 v[222:223], v31 offset:2048
  ds_read_b64_tr_b16 v[224:225], v28 offset:4096
  ds_read_b64_tr_b16 v[226:227], v28 offset:6144
  ds_read_b64_tr_b16 v[228:229], v29 offset:4096
  ds_read_b64_tr_b16 v[230:231], v29 offset:6144
  ds_read_b64_tr_b16 v[232:233], v30 offset:4096
  ds_read_b64_tr_b16 v[234:235], v30 offset:6144
  ds_read_b64_tr_b16 v[236:237], v31 offset:4096
  ds_read_b64_tr_b16 v[238:239], v31 offset:6144
  v_mul_f32 v112, v112, v8
  v_mul_f32 v113, v113, v8
  v_mul_f32 v114, v114, v8
  v_mul_f32 v115, v115, v8
  v_mul_f32 v116, v116, v8
  v_mul_f32 v117, v117, v8
  v_mul_f32 v118, v118, v8
  v_mul_f32 v119, v119, v8
  v_mul_f32 v120, v120, v8
  v_mul_f32 v121, v121, v8
  v_mul_f32 v122, v122, v8
  v_mul_f32 v123, v123, v8
  v_mul_f32 v124, v124, v8
  v_mul_f32 v125, v125, v8
  v_mul_f32 v126, v126, v8
  v_mul_f32 v127, v127, v8
  v_mul_f32 v128, v128, v8
  v_mul_f32 v129, v129, v8
  v_mul_f32 v130, v130, v8
  v_mul_f32 v131, v131, v8
  v_mul_f32 v132, v132, v8
  v_mul_f32 v133, v133, v8
  v_mul_f32 v134, v134, v8
  v_mul_f32 v135, v135, v8
  v_mul_f32 v136, v136, v8
  v_mul_f32 v137, v137, v8
  v_mul_f32 v138, v138, v8
  v_mul_f32 v139, v139, v8
  v_mul_f32 v140, v140, v8
  v_mul_f32 v141, v141, v8
  v_mul_f32 v142, v142, v8
  v_mul_f32 v143, v143, v8
  v_mul_f32 v144, v144, v8
  v_mul_f32 v145, v145, v8
  v_mul_f32 v146, v146, v8
  v_mul_f32 v147, v147, v8
  v_mul_f32 v148, v148, v8
  v_mul_f32 v149, v149, v8
  v_mul_f32 v150, v150, v8
  v_mul_f32 v151, v151, v8
  v_mul_f32 v152, v152, v8
  v_mul_f32 v153, v153, v8
  v_mul_f32 v154, v154, v8
  v_mul_f32 v155, v155, v8
  v_mul_f32 v156, v156, v8
  v_mul_f32 v157, v157, v8
  v_mul_f32 v158, v158, v8
  v_mul_f32 v159, v159, v8
  v_mul_f32 v160, v160, v8
  v_mul_f32 v161, v161, v8
  v_mul_f32 v162, v162, v8
  v_mul_f32 v163, v163, v8
  v_mul_f32 v164, v164, v8
  v_mul_f32 v165, v165, v8
  v_mul_f32 v166, v166, v8
  v_mul_f32 v167, v167, v8
  v_mul_f32 v168, v168, v8
  v_mul_f32 v169, v169, v8
  v_mul_f32 v170, v170, v8
  v_mul_f32 v171, v171, v8
  v_mul_f32 v172, v172, v8
  v_mul_f32 v173, v173, v8
  v_mul_f32 v174, v174, v8
  v_mul_f32 v175, v175, v8
  s_waitcnt lgkmcnt(14)
  v_mfma_f32_32x32x16_bf16 v[112:127], v[208:211], v[96:99], v[112:127]
  s_waitcnt lgkmcnt(12)
  v_mfma_f32_32x32x16_bf16 v[128:143], v[212:215], v[96:99], v[128:143]
  s_waitcnt lgkmcnt(10)
  v_mfma_f32_32x32x16_bf16 v[144:159], v[216:219], v[96:99], v[144:159]
  s_waitcnt lgkmcnt(8)
  v_mfma_f32_32x32x16_bf16 v[160:175], v[220:223], v[96:99], v[160:175]
  s_waitcnt lgkmcnt(6)
  v_mfma_f32_32x32x16_bf16 v[112:127], v[224:227], v[100:103], v[112:127]
  s_waitcnt lgkmcnt(4)
  v_mfma_f32_32x32x16_bf16 v[128:143], v[228:231], v[100:103], v[128:143]
  s_waitcnt lgkmcnt(2)
  v_mfma_f32_32x32x16_bf16 v[144:159], v[232:235], v[100:103], v[144:159]
  s_waitcnt lgkmcnt(0)
  v_mfma_f32_32x32x16_bf16 v[160:175], v[236:239], v[100:103], v[160:175]
  ds_read_b64_tr_b16 v[208:209], v28 offset:8192
  ds_read_b64_tr_b16 v[210:211], v28 offset:10240
  ds_read_b64_tr_b16 v[212:213], v29 offset:8192
  ds_read_b64_tr_b16 v[214:215], v29 offset:10240
  ds_read_b64_tr_b16 v[216:217], v30 offset:8192
  ds_read_b64_tr_b16 v[218:219], v30 offset:10240
  ds_read_b64_tr_b16 v[220:221], v31 offset:8192
  ds_read_b64_tr_b16 v[222:223], v31 offset:10240
  ds_read_b64_tr_b16 v[224:225], v28 offset:12288
  ds_read_b64_tr_b16 v[226:227], v28 offset:14336
  ds_read_b64_tr_b16 v[228:229], v29 offset:12288
  ds_read_b64_tr_b16 v[230:231], v29 offset:14336
  ds_read_b64_tr_b16 v[232:233], v30 offset:12288
  ds_read_b64_tr_b16 v[234:235], v30 offset:14336
  ds_read_b64_tr_b16 v[236:237], v31 offset:12288
  ds_read_b64_tr_b16 v[238:239], v31 offset:14336
  s_waitcnt lgkmcnt(14)
  v_mfma_f32_32x32x16_bf16 v[112:127], v[208:211], v[104:107], v[112:127]
  s_waitcnt lgkmcnt(12)
  v_mfma_f32_32x32x16_bf16 v[128:143], v[212:215], v[104:107], v[128:143]
  s_waitcnt lgkmcnt(10)
  v_mfma_f32_32x32x16_bf16 v[144:159], v[216:219], v[104:107], v[144:159]
  s_waitcnt lgkmcnt(8)
  v_mfma_f32_32x32x16_bf16 v[160:175], v[220:223], v[104:107], v[160:175]
  s_waitcnt lgkmcnt(6)
  v_mfma_f32_32x32x16_bf16 v[112:127], v[224:227], v[108:111], v[112:127]
  s_waitcnt lgkmcnt(4)
  v_mfma_f32_32x32x16_bf16 v[128:143], v[228:231], v[108:111], v[128:143]
  s_waitcnt lgkmcnt(2)
  v_mfma_f32_32x32x16_bf16 v[144:159], v[232:235], v[108:111], v[144:159]
  s_waitcnt lgkmcnt(0)
  v_mfma_f32_32x32x16_bf16 v[160:175], v[236:239], v[108:111], v[160:175]
  s_add_u32 s3, s3, 1
  s_cmp_lt_u32 s3, 16
  s_cbranch_scc1 L1_loop
  v_mov_b32 v3, v7
  s_nop 1
  v_permlane32_swap_b32 v7, v3
  v_add_f32 v7, v7, v3
  v_lshlrev_b32 v2, 4, v1
  s_mul_i32 s3, s44, 17408
  v_add_u32 v2, s3, v2
  s_cmp_eq_u32 s43, 0
  s_cbranch_scc1 L1_ga
  s_nop 7
  s_nop 7
  s_waitcnt vmcnt(0)
  s_barrier
  ds_write_b128 v2, v[112:115] offset:0
  ds_write_b128 v2, v[116:119] offset:1024
  ds_write_b128 v2, v[120:123] offset:2048
  ds_write_b128 v2, v[124:127] offset:3072
  ds_write_b128 v2, v[128:131] offset:4096
  ds_write_b128 v2, v[132:135] offset:5120
  ds_write_b128 v2, v[136:139] offset:6144
  ds_write_b128 v2, v[140:143] offset:7168
  ds_write_b128 v2, v[144:147] offset:8192
  ds_write_b128 v2, v[148:151] offset:9216
  ds_write_b128 v2, v[152:155] offset:10240
  ds_write_b128 v2, v[156:159] offset:11264
  ds_write_b128 v2, v[160:163] offset:12288
  ds_write_b128 v2, v[164:167] offset:13312
  ds_write_b128 v2, v[168:171] offset:14336
  ds_write_b128 v2, v[172:175] offset:15360
  ds_write_b64 v2, v[6:7] offset:16384
  s_waitcnt lgkmcnt(0)
  s_barrier
  s_endpgm
L1_ga:
  s_waitcnt vmcnt(0)
  s_barrier
  s_barrier
  s_barrier
  ds_read_b64 v[4:5], v2 offset:16384
  ds_read_b128 v[32:35], v2 offset:0
  ds_read_b128 v[36:39], v2 offset:1024
  ds_read_b128 v[40:43], v2 offset:2048
  ds_read_b128 v[44:47], v2 offset:3072
  ds_read_b128 v[48:51], v2 offset:4096
  ds_read_b128 v[52:55], v2 offset:5120
  ds_read_b128 v[56:59], v2 offset:6144
  ds_read_b128 v[60:63], v2 offset:7168
  ds_read_b128 v[64:67], v2 offset:8192
  ds_read_b128 v[68:71], v2 offset:9216
  ds_read_b128 v[72:75], v2 offset:10240
  ds_read_b128 v[76:79], v2 offset:11264
  ds_read_b128 v[80:83], v2 offset:12288
  ds_read_b128 v[84:87], v2 offset:13312
  ds_read_b128 v[88:91], v2 offset:14336
  ds_read_b128 v[92:95], v2 offset:15360
  s_waitcnt lgkmcnt(15)
  v_max_f32 v3, v6, v4
  v_sub_f32 v6, v6, v3
  v_sub_f32 v4, v4, v3
  v_mul_f32 v6, s37, v6
  v_mul_f32 v4, s37, v4
  v_exp_f32 v6, v6
  v_exp_f32 v4, v4
  s_nop 0
  v_mul_f32 v7, v7, v6
  v_fma_f32 v7, v5, v4, v7
  v_rcp_f32 v8, v7
  s_nop 0
  v_mul_f32 v6, v6, v8
  v_mul_f32 v4, v4, v8
  v_and_b32 v2, 31, v1
  v_lshrrev_b32 v5, 5, v1
  v_lshlrev_b32 v2, 13, v2
  v_lshl_add_u32 v2, v5, 4, v2
  s_waitcnt lgkmcnt(0)
  v_mul_f32 v112, v112, v6
  v_fma_f32 v112, v32, v4, v112
  v_mul_f32 v113, v113, v6
  v_fma_f32 v113, v33, v4, v113
  v_mul_f32 v114, v114, v6
  v_fma_f32 v114, v34, v4, v114
  v_mul_f32 v115, v115, v6
  v_fma_f32 v115, v35, v4, v115
  v_mul_f32 v116, v116, v6
  v_fma_f32 v116, v36, v4, v116
  v_mul_f32 v117, v117, v6
  v_fma_f32 v117, v37, v4, v117
  v_mul_f32 v118, v118, v6
  v_fma_f32 v118, v38, v4, v118
  v_mul_f32 v119, v119, v6
  v_fma_f32 v119, v39, v4, v119
  v_mul_f32 v120, v120, v6
  v_fma_f32 v120, v40, v4, v120
  v_mul_f32 v121, v121, v6
  v_fma_f32 v121, v41, v4, v121
  v_mul_f32 v122, v122, v6
  v_fma_f32 v122, v42, v4, v122
  v_mul_f32 v123, v123, v6
  v_fma_f32 v123, v43, v4, v123
  v_mul_f32 v124, v124, v6
  v_fma_f32 v124, v44, v4, v124
  v_mul_f32 v125, v125, v6
  v_fma_f32 v125, v45, v4, v125
  v_mul_f32 v126, v126, v6
  v_fma_f32 v126, v46, v4, v126
  v_mul_f32 v127, v127, v6
  v_fma_f32 v127, v47, v4, v127
  v_mul_f32 v128, v128, v6
  v_fma_f32 v128, v48, v4, v128
  v_mul_f32 v129, v129, v6
  v_fma_f32 v129, v49, v4, v129
  v_mul_f32 v130, v130, v6
  v_fma_f32 v130, v50, v4, v130
  v_mul_f32 v131, v131, v6
  v_fma_f32 v131, v51, v4, v131
  v_mul_f32 v132, v132, v6
  v_fma_f32 v132, v52, v4, v132
  v_mul_f32 v133, v133, v6
  v_fma_f32 v133, v53, v4, v133
  v_mul_f32 v134, v134, v6
  v_fma_f32 v134, v54, v4, v134
  v_mul_f32 v135, v135, v6
  v_fma_f32 v135, v55, v4, v135
  v_mul_f32 v136, v136, v6
  v_fma_f32 v136, v56, v4, v136
  v_mul_f32 v137, v137, v6
  v_fma_f32 v137, v57, v4, v137
  v_mul_f32 v138, v138, v6
  v_fma_f32 v138, v58, v4, v138
  v_mul_f32 v139, v139, v6
  v_fma_f32 v139, v59, v4, v139
  v_mul_f32 v140, v140, v6
  v_fma_f32 v140, v60, v4, v140
  v_mul_f32 v141, v141, v6
  v_fma_f32 v141, v61, v4, v141
  v_mul_f32 v142, v142, v6
  v_fma_f32 v142, v62, v4, v142
  v_mul_f32 v143, v143, v6
  v_fma_f32 v143, v63, v4, v143
  v_mul_f32 v144, v144, v6
  v_fma_f32 v144, v64, v4, v144
  v_mul_f32 v145, v145, v6
  v_fma_f32 v145, v65, v4, v145
  v_mul_f32 v146, v146, v6
  v_fma_f32 v146, v66, v4, v146
  v_mul_f32 v147, v147, v6
  v_fma_f32 v147, v67, v4, v147
  v_mul_f32 v148, v148, v6
  v_fma_f32 v148, v68, v4, v148
  v_mul_f32 v149, v149, v6
  v_fma_f32 v149, v69, v4, v149
  v_mul_f32 v150, v150, v6
  v_fma_f32 v150, v70, v4, v150
  v_mul_f32 v151, v151, v6
  v_fma_f32 v151, v71, v4, v151
  v_mul_f32 v152, v152, v6
  v_fma_f32 v152, v72, v4, v152
  v_mul_f32 v153, v153, v6
  v_fma_f32 v153, v73, v4, v153
  v_mul_f32 v154, v154, v6
  v_fma_f32 v154, v74, v4, v154
  v_mul_f32 v155, v155, v6
  v_fma_f32 v155, v75, v4, v155
  v_mul_f32 v156, v156, v6
  v_fma_f32 v156, v76, v4, v156
  v_mul_f32 v157, v157, v6
  v_fma_f32 v157, v77, v4, v157
  v_mul_f32 v158, v158, v6
  v_fma_f32 v158, v78, v4, v158
  v_mul_f32 v159, v159, v6
  v_fma_f32 v159, v79, v4, v159
  v_mul_f32 v160, v160, v6
  v_fma_f32 v160, v80, v4, v160
  v_mul_f32 v161, v161, v6
  v_fma_f32 v161, v81, v4, v161
  v_mul_f32 v162, v162, v6
  v_fma_f32 v162, v82, v4, v162
  v_mul_f32 v163, v163, v6
  v_fma_f32 v163, v83, v4, v163
  v_mul_f32 v164, v164, v6
  v_fma_f32 v164, v84, v4, v164
  v_mul_f32 v165, v165, v6
  v_fma_f32 v165, v85, v4, v165
  v_mul_f32 v166, v166, v6
  v_fma_f32 v166, v86, v4, v166
  v_mul_f32 v167, v167, v6
  v_fma_f32 v167, v87, v4, v167
  v_mul_f32 v168, v168, v6
  v_fma_f32 v168, v88, v4, v168
  v_mul_f32 v169, v169, v6
  v_fma_f32 v169, v89, v4, v169
  v_mul_f32 v170, v170, v6
  v_fma_f32 v170, v90, v4, v170
  v_mul_f32 v171, v171, v6
  v_fma_f32 v171, v91, v4, v171
  v_mul_f32 v172, v172, v6
  v_fma_f32 v172, v92, v4, v172
  v_mul_f32 v173, v173, v6
  v_fma_f32 v173, v93, v4, v173
  v_mul_f32 v174, v174, v6
  v_fma_f32 v174, v94, v4, v174
  v_mul_f32 v175, v175, v6
  v_fma_f32 v175, v95, v4, v175
  v_cvt_pk_bf16_f32 v176, v112, v113
  v_cvt_pk_bf16_f32 v177, v114, v115
  v_cvt_pk_bf16_f32 v178, v116, v117
  v_cvt_pk_bf16_f32 v179, v118, v119
  s_nop 1
  v_permlane32_swap_b32 v176, v178
  v_permlane32_swap_b32 v177, v179
  buffer_store_dwordx4 v[176:179], v2, s[32:35], s47 offen offset:0
  v_cvt_pk_bf16_f32 v180, v120, v121
  v_cvt_pk_bf16_f32 v181, v122, v123
  v_cvt_pk_bf16_f32 v182, v124, v125
  v_cvt_pk_bf16_f32 v183, v126, v127
  s_nop 1
  v_permlane32_swap_b32 v180, v182
  v_permlane32_swap_b32 v181, v183
  buffer_store_dwordx4 v[180:183], v2, s[32:35], s47 offen offset:32
  v_cvt_pk_bf16_f32 v184, v128, v129
  v_cvt_pk_bf16_f32 v185, v130, v131
  v_cvt_pk_bf16_f32 v186, v132, v133
  v_cvt_pk_bf16_f32 v187, v134, v135
  s_nop 1
  v_permlane32_swap_b32 v184, v186
  v_permlane32_swap_b32 v185, v187
  buffer_store_dwordx4 v[184:187], v2, s[32:35], s47 offen offset:64
  v_cvt_pk_bf16_f32 v188, v136, v137
  v_cvt_pk_bf16_f32 v189, v138, v139
  v_cvt_pk_bf16_f32 v190, v140, v141
  v_cvt_pk_bf16_f32 v191, v142, v143
  s_nop 1
  v_permlane32_swap_b32 v188, v190
  v_permlane32_swap_b32 v189, v191
  buffer_store_dwordx4 v[188:191], v2, s[32:35], s47 offen offset:96
  v_cvt_pk_bf16_f32 v192, v144, v145
  v_cvt_pk_bf16_f32 v193, v146, v147
  v_cvt_pk_bf16_f32 v194, v148, v149
  v_cvt_pk_bf16_f32 v195, v150, v151
  s_nop 1
  v_permlane32_swap_b32 v192, v194
  v_permlane32_swap_b32 v193, v195
  buffer_store_dwordx4 v[192:195], v2, s[32:35], s47 offen offset:128
  v_cvt_pk_bf16_f32 v196, v152, v153
  v_cvt_pk_bf16_f32 v197, v154, v155
  v_cvt_pk_bf16_f32 v198, v156, v157
  v_cvt_pk_bf16_f32 v199, v158, v159
  s_nop 1
  v_permlane32_swap_b32 v196, v198
  v_permlane32_swap_b32 v197, v199
  buffer_store_dwordx4 v[196:199], v2, s[32:35], s47 offen offset:160
  v_cvt_pk_bf16_f32 v200, v160, v161
  v_cvt_pk_bf16_f32 v201, v162, v163
  v_cvt_pk_bf16_f32 v202, v164, v165
  v_cvt_pk_bf16_f32 v203, v166, v167
  s_nop 1
  v_permlane32_swap_b32 v200, v202
  v_permlane32_swap_b32 v201, v203
  buffer_store_dwordx4 v[200:203], v2, s[32:35], s47 offen offset:192
  v_cvt_pk_bf16_f32 v204, v168, v169
  v_cvt_pk_bf16_f32 v205, v170, v171
  v_cvt_pk_bf16_f32 v206, v172, v173
  v_cvt_pk_bf16_f32 v207, v174, v175
  s_nop 1
  v_permlane32_swap_b32 v204, v206
  v_permlane32_swap_b32 v205, v207
  buffer_store_dwordx4 v[204:207], v2, s[32:35], s47 offen offset:224
L1_done:
  s_endpgm
.globl oproj_kernel
.p2align 8
.type oproj_kernel,@function
oproj_kernel:
  s_cmp_ge_u32 s2, 256
  s_cbranch_scc1 L2_done
  s_load_dwordx4 s[4:7], s[0:1], 32
  s_load_dwordx2 s[8:9], s[0:1], 56
  v_and_b32 v1, 63, v0
  v_lshrrev_b32 v2, 6, v0
  s_nop 0
  v_readfirstlane_b32 s36, v2
  s_bfe_u32 s14, s2, 0x20001
  s_lshl_b32 s14, s14, 2
  s_bfe_u32 s15, s2, 0x20006
  s_add_u32 s14, s14, s15
  s_and_b32 s15, s2, 1
  s_lshl_b32 s15, s15, 3
  s_bfe_u32 s3, s2, 0x30003
  s_add_u32 s15, s15, s3
  s_waitcnt lgkmcnt(0)
  s_lshl_b32 s3, s14, 19
  s_add_u32 s16, s8, s3
  s_addc_u32 s17, s9, 0
  s_mov_b32 s18, 0x80000
  s_mov_b32 s19, 0x20000
  s_lshl_b32 s3, s15, 6
  s_add_u32 s20, s4, s3
  s_addc_u32 s21, s5, 0
  s_sub_u32 s22, 0x400000, s3
  s_mov_b32 s23, 0x20000
  s_lshl_b32 s14, s14, 16
  s_add_u32 s14, s14, s3
  s_add_u32 s24, s6, s14
  s_addc_u32 s25, s7, 0
  s_sub_u32 s26, 0x10000, s3
  s_mov_b32 s27, 0x20000
  v_lshrrev_b32 v5, 5, v1
  v_and_b32 v2, 31, v1
  v_xor_b32 v3, v2, v5
  v_lshlrev_b32 v3, 4, v3
  v_lshl_add_u32 v3, v5, 13, v3
  v_xor_b32 v8, 0, v3
  v_xor_b32 v9, 32, v3
  v_xor_b32 v10, 64, v3
  v_xor_b32 v11, 96, v3
  v_xor_b32 v12, 128, v3
  v_xor_b32 v13, 160, v3
  v_xor_b32 v14, 192, v3
  v_xor_b32 v15, 224, v3
  v_lshrrev_b32 v2, 2, v1
  v_and_b32 v3, 3, v1
  v_lshlrev_b32 v3, 4, v3
  v_lshl_add_u32 v7, v2, 10, v3
  v_lshrrev_b32 v2, 2, v1
  v_and_b32 v2, 3, v2
  v_and_b32 v3, 3, v1
  v_lshlrev_b32 v3, 3, v3
  v_bfe_u32 v4, v1, 4, 1
  v_lshl_add_u32 v3, v4, 5, v3
  v_lshl_add_u32 v3, v2, 6, v3
  v_lshl_add_u32 v3, v5, 9, v3
  s_lshl_b32 s37, s36, 12
  s_add_u32 s37, s37, 32768
  v_add_u32 v22, s37, v3
  s_lshl_b32 s37, s36, 3
  v_and_b32 v2, 15, v1
  v_xor_b32 v2, v2, v5
  v_xor_b32 v2, s37, v2
  v_lshlrev_b32 v2, 4, v2
  v_and_b32 v3, 31, v1
  v_lshl_add_u32 v21, v3, 9, v2
  s_lshl_b32 s38, s36, 17
  s_lshl_b32 s39, s36, 16
  s_lshl_b32 s41, s36, 13
  s_lshl_b32 s42, s36, 12
  s_add_u32 s42, s42, 32768
  s_mov_b32 s43, 0
  s_mov_b32 s44, 0
  v_mov_b32 v176, 0
  v_mov_b32 v177, 0
  v_mov_b32 v178, 0
  v_mov_b32 v179, 0
  v_mov_b32 v180, 0
  v_mov_b32 v181, 0
  v_mov_b32 v182, 0
  v_mov_b32 v183, 0
  v_mov_b32 v184, 0
  v_mov_b32 v185, 0
  v_mov_b32 v186, 0
  v_mov_b32 v187, 0
  v_mov_b32 v188, 0
  v_mov_b32 v189, 0
  v_mov_b32 v190, 0
  v_mov_b32 v191, 0
  v_mov_b32 v192, 0
  v_mov_b32 v193, 0
  v_mov_b32 v194, 0
  v_mov_b32 v195, 0
  v_mov_b32 v196, 0
  v_mov_b32 v197, 0
  v_mov_b32 v198, 0
  v_mov_b32 v199, 0
  v_mov_b32 v200, 0
  v_mov_b32 v201, 0
  v_mov_b32 v202, 0
  v_mov_b32 v203, 0
  v_mov_b32 v204, 0
  v_mov_b32 v205, 0
  v_mov_b32 v206, 0
  v_mov_b32 v207, 0
  s_add_u32 s45, s41, s43
  s_add_u32 m0, s45, 0
  s_add_u32 s40, s38, 0
  buffer_load_dwordx4 v8, s[16:19], s40 offen lds
  s_add_u32 m0, s45, 1024
  s_add_u32 s40, s38, 16384
  buffer_load_dwordx4 v9, s[16:19], s40 offen lds
  s_add_u32 m0, s45, 2048
  s_add_u32 s40, s38, 32768
  buffer_load_dwordx4 v10, s[16:19], s40 offen lds
  s_add_u32 m0, s45, 3072
  s_add_u32 s40, s38, 49152
  buffer_load_dwordx4 v11, s[16:19], s40 offen lds
  s_add_u32 m0, s45, 4096
  s_add_u32 s40, s38, 65536
  buffer_load_dwordx4 v12, s[16:19], s40 offen lds
  s_add_u32 m0, s45, 5120
  s_add_u32 s40, s38, 81920
  buffer_load_dwordx4 v13, s[16:19], s40 offen lds
  s_add_u32 m0, s45, 6144
  s_add_u32 s40, s38, 98304
  buffer_load_dwordx4 v14, s[16:19], s40 offen lds
  s_add_u32 m0, s45, 7168
  s_add_u32 s40, s38, 114688
  buffer_load_dwordx4 v15, s[16:19], s40 offen lds
  s_add_u32 s45, s42, s43
  s_add_u32 m0, s45, 0
  s_add_u32 s40, s39, 0
  buffer_load_dwordx4 v7, s[20:23], s40 offen lds
  s_add_u32 m0, s45, 1024
  s_add_u32 s40, s39, 16384
  buffer_load_dwordx4 v7, s[20:23], s40 offen lds
  s_add_u32 m0, s45, 2048
  s_add_u32 s40, s39, 32768
  buffer_load_dwordx4 v7, s[20:23], s40 offen lds
  s_add_u32 m0, s45, 3072
  s_add_u32 s40, s39, 49152
  buffer_load_dwordx4 v7, s[20:23], s40 offen lds
  s_add_u32 s38, s38, 512
  s_add_u32 s39, s39, 0x40000
  s_add_u32 s43, s43, 49152
  s_cmp_ge_u32 s43, 147456
  s_cselect_b32 s43, 0, s43
  s_add_u32 s45, s41, s43
  s_add_u32 m0, s45, 0
  s_add_u32 s40, s38, 0
  buffer_load_dwordx4 v8, s[16:19], s40 offen lds
  s_add_u32 m0, s45, 1024
  s_add_u32 s40, s38, 16384
  buffer_load_dwordx4 v9, s[16:19], s40 offen lds
  s_add_u32 m0, s45, 2048
  s_add_u32 s40, s38, 32768
  buffer_load_dwordx4 v10, s[16:19], s40 offen lds
  s_add_u32 m0, s45, 3072
  s_add_u32 s40, s38, 49152
  buffer_load_dwordx4 v11, s[16:19], s40 offen lds
  s_add_u32 m0, s45, 4096
  s_add_u32 s40, s38, 65536
  buffer_load_dwordx4 v12, s[16:19], s40 offen lds
  s_add_u32 m0, s45, 5120
  s_add_u32 s40, s38, 81920
  buffer_load_dwordx4 v13, s[16:19], s40 offen lds
  s_add_u32 m0, s45, 6144
  s_add_u32 s40, s38, 98304
  buffer_load_dwordx4 v14, s[16:19], s40 offen lds
  s_add_u32 m0, s45, 7168
  s_add_u32 s40, s38, 114688
  buffer_load_dwordx4 v15, s[16:19], s40 offen lds
  s_add_u32 s45, s42, s43
  s_add_u32 m0, s45, 0
  s_add_u32 s40, s39, 0
  buffer_load_dwordx4 v7, s[20:23], s40 offen lds
  s_add_u32 m0, s45, 1024
  s_add_u32 s40, s39, 16384
  buffer_load_dwordx4 v7, s[20:23], s40 offen lds
  s_add_u32 m0, s45, 2048
  s_add_u32 s40, s39, 32768
  buffer_load_dwordx4 v7, s[20:23], s40 offen lds
  s_add_u32 m0, s45, 3072
  s_add_u32 s40, s39, 49152
  buffer_load_dwordx4 v7, s[20:23], s40 offen lds
  s_add_u32 s38, s38, 512
  s_add_u32 s39, s39, 0x40000
  s_add_u32 s43, s43, 49152
  s_cmp_ge_u32 s43, 147456
  s_cselect_b32 s43, 0, s43
  s_mov_b32 s3, 0
L2_loop:
  v_xor_b32 v16, 0, v21
  v_add_u32 v16, s44, v16
  v_xor_b32 v17, 32, v21
  v_add_u32 v17, s44, v17
  v_xor_b32 v18, 64, v21
  v_add_u32 v18, s44, v18
  v_xor_b32 v19, 96, v21
  v_add_u32 v19, s44, v19
  v_add_u32 v20, s44, v22
  s_add_u32 s44, s44, 49152
  s_cmp_ge_u32 s44, 147456
  s_cselect_b32 s44, 0, s44
  s_waitcnt vmcnt(12)
  s_barrier
  s_add_u32 s45, s41, s43
  s_add_u32 m0, s45, 0
  s_add_u32 s40, s38, 0
  buffer_load_dwordx4 v8, s[16:19], s40 offen lds
  s_add_u32 m0, s45, 1024
  s_add_u32 s40, s38, 16384
  buffer_load_dwordx4 v9, s[16:19], s40 offen lds
  s_add_u32 m0, s45, 2048
  s_add_u32 s40, s38, 32768
  buffer_load_dwordx4 v10, s[16:19], s40 offen lds
  s_add_u32 m0, s45, 3072
  s_add_u32 s40, s38, 49152
  buffer_load_dwordx4 v11, s[16:19], s40 offen lds
  s_add_u32 m0, s45, 4096
  s_add_u32 s40, s38, 65536
  buffer_load_dwordx4 v12, s[16:19], s40 offen lds
  s_add_u32 m0, s45, 5120
  s_add_u32 s40, s38, 81920
  buffer_load_dwordx4 v13, s[16:19], s40 offen lds
  s_add_u32 m0, s45, 6144
  s_add_u32 s40, s38, 98304
  buffer_load_dwordx4 v14, s[16:19], s40 offen lds
  s_add_u32 m0, s45, 7168
  s_add_u32 s40, s38, 114688
  buffer_load_dwordx4 v15, s[16:19], s40 offen lds
  s_add_u32 s45, s42, s43
  s_add_u32 m0, s45, 0
  s_add_u32 s40, s39, 0
  buffer_load_dwordx4 v7, s[20:23], s40 offen lds
  s_add_u32 m0, s45, 1024
  s_add_u32 s40, s39, 16384
  buffer_load_dwordx4 v7, s[20:23], s40 offen lds
  s_add_u32 m0, s45, 2048
  s_add_u32 s40, s39, 32768
  buffer_load_dwordx4 v7, s[20:23], s40 offen lds
  s_add_u32 m0, s45, 3072
  s_add_u32 s40, s39, 49152
  buffer_load_dwordx4 v7, s[20:23], s40 offen lds
  s_add_u32 s38, s38, 512
  s_add_u32 s39, s39, 0x40000
  s_add_u32 s43, s43, 49152
  s_cmp_ge_u32 s43, 147456
  s_cselect_b32 s43, 0, s43
  ds_read_b64_tr_b16 v[56:57], v20 offset:0
  ds_read_b64_tr_b16 v[58:59], v20 offset:256
  ds_read_b128 v[24:27], v16 offset:0
  ds_read_b128 v[28:31], v16 offset:16384
  ds_read_b64_tr_b16 v[60:61], v20 offset:1024
  ds_read_b64_tr_b16 v[62:63], v20 offset:1280
  ds_read_b128 v[32:35], v17 offset:0
  ds_read_b128 v[36:39], v17 offset:16384
  ds_read_b64_tr_b16 v[64:65], v20 offset:2048
  ds_read_b64_tr_b16 v[66:67], v20 offset:2304
  ds_read_b128 v[40:43], v18 offset:0
  ds_read_b128 v[44:47], v18 offset:16384
  ds_read_b64_tr_b16 v[68:69], v20 offset:3072
  ds_read_b64_tr_b16 v[70:71], v20 offset:3328
  ds_read_b128 v[48:51], v19 offset:0
  ds_read_b128 v[52:55], v19 offset:16384
  s_waitcnt lgkmcnt(13)
  v_mfma_f32_32x32x16_bf16 v[176:191], v[56:59], v[24:27], v[176:191]
  s_waitcnt lgkmcnt(12)
  v_mfma_f32_32x32x16_bf16 v[192:207], v[56:59], v[28:31], v[192:207]
  s_waitcnt lgkmcnt(9)
  v_mfma_f32_32x32x16_bf16 v[176:191], v[60:63], v[32:35], v[176:191]
  s_waitcnt lgkmcnt(8)
  v_mfma_f32_32x32x16_bf16 v[192:207], v[60:63], v[36:39], v[192:207]
  s_waitcnt lgkmcnt(5)
  v_mfma_f32_32x32x16_bf16 v[176:191], v[64:67], v[40:43], v[176:191]
  s_waitcnt lgkmcnt(4)
  v_mfma_f32_32x32x16_bf16 v[192:207], v[64:67], v[44:47], v[192:207]
  s_waitcnt lgkmcnt(1)
  v_mfma_f32_32x32x16_bf16 v[176:191], v[68:71], v[48:51], v[176:191]
  s_waitcnt lgkmcnt(0)
  v_mfma_f32_32x32x16_bf16 v[192:207], v[68:71], v[52:55], v[192:207]
  s_add_u32 s3, s3, 1
  s_cmp_lt_u32 s3, 16
  s_cbranch_scc1 L2_loop
  s_waitcnt vmcnt(0)
  s_nop 7
  s_nop 7
  s_barrier
  v_lshlrev_b32 v2, 2, v1
  s_lshl_b32 s37, s36, 13
  v_add_u32 v3, s37, v2
  ds_write_b32 v3, v176 offset:0
  ds_write_b32 v3, v177 offset:256
  ds_write_b32 v3, v178 offset:512
  ds_write_b32 v3, v179 offset:768
  ds_write_b32 v3, v180 offset:1024
  ds_write_b32 v3, v181 offset:1280
  ds_write_b32 v3, v182 offset:1536
  ds_write_b32 v3, v183 offset:1792
  ds_write_b32 v3, v184 offset:2048
  ds_write_b32 v3, v185 offset:2304
  ds_write_b32 v3, v186 offset:2560
  ds_write_b32 v3, v187 offset:2816
  ds_write_b32 v3, v188 offset:3072
  ds_write_b32 v3, v189 offset:3328
  ds_write_b32 v3, v190 offset:3584
  ds_write_b32 v3, v191 offset:3840
  ds_write_b32 v3, v192 offset:4096
  ds_write_b32 v3, v193 offset:4352
  ds_write_b32 v3, v194 offset:4608
  ds_write_b32 v3, v195 offset:4864
  ds_write_b32 v3, v196 offset:5120
  ds_write_b32 v3, v197 offset:5376
  ds_write_b32 v3, v198 offset:5632
  ds_write_b32 v3, v199 offset:5888
  ds_write_b32 v3, v200 offset:6144
  ds_write_b32 v3, v201 offset:6400
  ds_write_b32 v3, v202 offset:6656
  ds_write_b32 v3, v203 offset:6912
  ds_write_b32 v3, v204 offset:7168
  ds_write_b32 v3, v205 offset:7424
  ds_write_b32 v3, v206 offset:7680
  ds_write_b32 v3, v207 offset:7936
  s_waitcnt lgkmcnt(0)
  s_barrier
  s_lshl_b32 s37, s36, 11
  v_add_u32 v3, s37, v2
  ds_read_b32 v16, v3 offset:0
  ds_read_b32 v17, v3 offset:256
  ds_read_b32 v18, v3 offset:512
  ds_read_b32 v19, v3 offset:768
  ds_read_b32 v20, v3 offset:1024
  ds_read_b32 v21, v3 offset:1280
  ds_read_b32 v22, v3 offset:1536
  ds_read_b32 v23, v3 offset:1792
  ds_read_b32 v24, v3 offset:8192
  ds_read_b32 v25, v3 offset:8448
  ds_read_b32 v26, v3 offset:8704
  ds_read_b32 v27, v3 offset:8960
  ds_read_b32 v28, v3 offset:9216
  ds_read_b32 v29, v3 offset:9472
  ds_read_b32 v30, v3 offset:9728
  ds_read_b32 v31, v3 offset:9984
  ds_read_b32 v32, v3 offset:16384
  ds_read_b32 v33, v3 offset:16640
  ds_read_b32 v34, v3 offset:16896
  ds_read_b32 v35, v3 offset:17152
  ds_read_b32 v36, v3 offset:17408
  ds_read_b32 v37, v3 offset:17664
  ds_read_b32 v38, v3 offset:17920
  ds_read_b32 v39, v3 offset:18176
  ds_read_b32 v40, v3 offset:24576
  ds_read_b32 v41, v3 offset:24832
  ds_read_b32 v42, v3 offset:25088
  ds_read_b32 v43, v3 offset:25344
  ds_read_b32 v44, v3 offset:25600
  ds_read_b32 v45, v3 offset:25856
  ds_read_b32 v46, v3 offset:26112
  ds_read_b32 v47, v3 offset:26368
  s_waitcnt lgkmcnt(0)
  v_add_f32 v16, v16, v24
  v_add_f32 v32, v32, v40
  v_add_f32 v17, v17, v25
  v_add_f32 v33, v33, v41
  v_add_f32 v18, v18, v26
  v_add_f32 v34, v34, v42
  v_add_f32 v19, v19, v27
  v_add_f32 v35, v35, v43
  v_add_f32 v20, v20, v28
  v_add_f32 v36, v36, v44
  v_add_f32 v21, v21, v29
  v_add_f32 v37, v37, v45
  v_add_f32 v22, v22, v30
  v_add_f32 v38, v38, v46
  v_add_f32 v23, v23, v31
  v_add_f32 v39, v39, v47
  v_add_f32 v16, v16, v32
  v_add_f32 v17, v17, v33
  v_add_f32 v18, v18, v34
  v_add_f32 v19, v19, v35
  v_add_f32 v20, v20, v36
  v_add_f32 v21, v21, v37
  v_add_f32 v22, v22, v38
  v_add_f32 v23, v23, v39
  v_cvt_pk_bf16_f32 v144, v16, v17
  v_cvt_pk_bf16_f32 v145, v18, v19
  v_cvt_pk_bf16_f32 v146, v20, v21
  v_cvt_pk_bf16_f32 v147, v22, v23
  s_nop 1
  v_permlane32_swap_b32 v144, v146
  v_permlane32_swap_b32 v145, v147
  v_and_b32 v2, 31, v1
  v_lshrrev_b32 v5, 5, v1
  v_lshlrev_b32 v2, 10, v2
  v_lshl_add_u32 v2, v5, 4, v2
  s_lshr_b32 s37, s36, 1
  s_lshl_b32 s37, s37, 15
  s_and_b32 s38, s36, 1
  s_lshl_b32 s38, s38, 5
  s_add_u32 s37, s37, s38
  buffer_store_dwordx4 v[144:147], v2, s[24:27], s37 offen
L2_done:
  s_endpgm
.section .rodata,"a"
.p2align 6
.amdhsa_kernel standalone__gqa_block_cached__near_ridge_kernel
  .amdhsa_next_free_vgpr 240
  .amdhsa_next_free_sgpr 64
  .amdhsa_accum_offset 240
  .amdhsa_group_segment_fixed_size 0
  .amdhsa_kernarg_size 64
  .amdhsa_user_sgpr_count 2
  .amdhsa_user_sgpr_kernarg_segment_ptr 1
  .amdhsa_system_sgpr_workgroup_id_x 1
.end_amdhsa_kernel
.p2align 6
.amdhsa_kernel oproj_kernel
  .amdhsa_next_free_vgpr 208
  .amdhsa_next_free_sgpr 64
  .amdhsa_accum_offset 208
  .amdhsa_group_segment_fixed_size 0
  .amdhsa_kernarg_size 64
  .amdhsa_user_sgpr_count 2
  .amdhsa_user_sgpr_kernarg_segment_ptr 1
  .amdhsa_system_sgpr_workgroup_id_x 1
.end_amdhsa_kernel
```
